```python
import torch

def _softmax(x, axis=-1):
    return torch.softmax(x, dim=axis)
def _gelu(x):
    return torch.nn.functional.gelu(x, approximate="tanh")
def _silu(x):
    return torch.nn.functional.silu(x)
def _sigmoid(x):
    return torch.sigmoid(x)
def _layernorm(x, axis=-1, eps=1e-5):
    m = x.mean(dim=axis, keepdim=True)
    v = x.var(dim=axis, keepdim=True, unbiased=False)
    return (x - m) / torch.sqrt(v + eps)
def _scatter_add(tgt, idx, src, axis=0):
    return tgt.clone().index_add_(axis, idx, src)
def _segment_sum(src, seg, n):
    out = torch.zeros((n,) + src.shape[1:], dtype=src.dtype)
    return out.index_add_(0, seg, src)
def _pad(x, pw):
    flat = tuple(v for pair in reversed(pw) for v in pair)
    return torch.nn.functional.pad(x, flat)

kernel_name = 'concat_heads__sliding_block_cached__sliding_block_cached__decode'

def setup_inputs():

    _w = (lambda a: (lambda t: t.to(torch.bfloat16) if t.is_floating_point() else t)(torch.as_tensor(a)))
    def _A_setup():
        B, Sq, D = 2, 1, 512
        Hq, Hkv, Sk, Dh = 32, 32, 8192, 128
        assert Hq % Hkv == 0, (Hq, Hkv)
        return {
            "x": _w((lambda *s: torch.randn(*s, dtype=torch.bfloat16) * 0.8)(B, Sq, D)),
            "k_cache": _w((lambda *s: torch.randn(*s, dtype=torch.bfloat16) * 1.6)(B, Hkv, Sk, Dh)),
            "v_cache": _w((lambda *s: torch.randn(*s, dtype=torch.bfloat16) * 0.2)(B, Hkv, Sk, Dh)),
            "wq": _w((lambda *s: torch.randn(*s, dtype=torch.bfloat16) * 1.6)(D, Hq * Dh) * (D ** -0.5)),
            "wo": _w((lambda *s: torch.randn(*s, dtype=torch.bfloat16) * 0.2)(Hq * Dh, D) * ((Hq * Dh) ** -0.5)),
        }
    _A_in = _A_setup()

    def _B_setup():
        B, Sq, D = 2, 1, 512
        Hq, Hkv, Sk, Dh = 32, 32, 8192, 128
        assert Hq % Hkv == 0, (Hq, Hkv)
        return {
            "x": _w((lambda *s: torch.randn(*s, dtype=torch.bfloat16) * 0.8)(B, Sq, D)),
            "k_cache": _w((lambda *s: torch.randn(*s, dtype=torch.bfloat16) * 1.6)(B, Hkv, Sk, Dh)),
            "v_cache": _w((lambda *s: torch.randn(*s, dtype=torch.bfloat16) * 0.2)(B, Hkv, Sk, Dh)),
            "wq": _w((lambda *s: torch.randn(*s, dtype=torch.bfloat16) * 1.6)(D, Hq * Dh) * (D ** -0.5)),
            "wo": _w((lambda *s: torch.randn(*s, dtype=torch.bfloat16) * 0.2)(Hq * Dh, D) * ((Hq * Dh) ** -0.5)),
        }
    _B_in = _B_setup()

    return {
        "A_x": _A_in["x"],
        "A_k_cache": _A_in["k_cache"],
        "A_v_cache": _A_in["v_cache"],
        "A_wq": _A_in["wq"],
        "A_wo": _A_in["wo"],
        "B_x": _B_in["x"],
        "B_k_cache": _B_in["k_cache"],
        "B_v_cache": _B_in["v_cache"],
        "B_wq": _B_in["wq"],
        "B_wo": _B_in["wo"],
    }

def reference(A_x, A_k_cache, A_v_cache, A_wq, A_wo, B_x, B_k_cache, B_v_cache, B_wq, B_wo):
    def _A_ref(x, k_cache, v_cache, wq, wo):
        B, Sq, D = x.shape
        Hq, Dh = 32, 128
        Hkv, Sk = k_cache.shape[1], k_cache.shape[2]
        W = min(4096, max(256, Sk // 4))
        rep = Hq // Hkv
        q = (lambda x, *d: x.permute(*d))((x @ wq).reshape(B, Sq, Hq, Dh), 0, 2, 1, 3)
        k = (lambda x, n, axis: torch.repeat_interleave(x, n, dim=axis))(k_cache[:, :, Sk - W:, :], rep, axis=1)
        v = (lambda x, n, axis: torch.repeat_interleave(x, n, dim=axis))(v_cache[:, :, Sk - W:, :], rep, axis=1)
        scores = torch.einsum("bhqd,bhkd->bhqk", q, k) * (Dh ** -0.5)
        p = _softmax(scores, axis=-1)
        o = torch.einsum("bhqk,bhkd->bhqd", p, v)
        return (lambda x, *d: x.permute(*d))(o, 0, 2, 1, 3).reshape(B, Sq, Hq * Dh) @ wo

    def _B_ref(x, k_cache, v_cache, wq, wo):
        B, Sq, D = x.shape
        Hq, Dh = 32, 128
        Hkv, Sk = k_cache.shape[1], k_cache.shape[2]
        W = min(4096, max(256, Sk // 4))
        rep = Hq // Hkv
        q = (lambda x, *d: x.permute(*d))((x @ wq).reshape(B, Sq, Hq, Dh), 0, 2, 1, 3)
        k = (lambda x, n, axis: torch.repeat_interleave(x, n, dim=axis))(k_cache[:, :, Sk - W:, :], rep, axis=1)
        v = (lambda x, n, axis: torch.repeat_interleave(x, n, dim=axis))(v_cache[:, :, Sk - W:, :], rep, axis=1)
        scores = torch.einsum("bhqd,bhkd->bhqk", q, k) * (Dh ** -0.5)
        p = _softmax(scores, axis=-1)
        o = torch.einsum("bhqk,bhkd->bhqd", p, v)
        return (lambda x, *d: x.permute(*d))(o, 0, 2, 1, 3).reshape(B, Sq, Hq * Dh) @ wo

    a = _A_ref(A_x, A_k_cache, A_v_cache, A_wq, A_wo)
    b = _B_ref(B_x, B_k_cache, B_v_cache, B_wq, B_wo)
    return torch.concatenate([a, b], axis=-1)
```

```asm
; @launch grid=(256,1,1) block=(512,1,1) lds=49152
.amdgcn_target "amdgcn-amd-amdhsa--gfx950"
.text
.globl concat_heads__sliding_block_cached__sliding_block_cached__decode_kernel
.p2align 8
.type concat_heads__sliding_block_cached__sliding_block_cached__decode_kernel,@function
concat_heads__sliding_block_cached__sliding_block_cached__decode_kernel:
    s_cmp_ge_u32 s2, 256
    s_cbranch_scc1 L_end1
    s_load_dwordx16 s[16:31], s[0:1], 0
    s_load_dwordx8 s[32:39], s[0:1], 64
    s_load_dwordx2 s[40:41], s[0:1], 96
    s_lshr_b32 s4, s2, 7
    s_bfe_u32 s13, s2, 0x20005
    s_lshl_b32 s5, s2, 2
    s_lshr_b32 s5, 0x62407531, s5
    s_and_b32 s5, s5, 7
    s_lshl3_add_u32 s5, s13, s5
    s_bfe_u32 s6, s2, 0x10004
    s_bfe_u32 s7, s2, 0x10003
    v_lshrrev_b32 v30, 6, v0
    v_and_b32 v1, 63, v0
    v_readfirstlane_b32 s8, v30
    v_lshrrev_b32 v6, 4, v1
    v_and_b32 v7, 15, v1
    s_lshl_b32 s9, s6, 8
    s_lshl3_add_u32 s13, s5, s7
    s_add_u32 s9, s9, s13
    s_add_u32 s9, s9, 6
    s_lshl_b32 s9, s9, 18
    s_lshl_b32 s10, s6, 10
    s_lshl_b32 s11, s5, 8
    v_and_b32 v3, 0x1c0, v0
    v_add_u32 v3, v3, v6
    v_lshl_add_u32 v5, v7, 2, v3
    v_lshlrev_b32 v5, 1, v5
    v_lshlrev_b32 v3, 13, v3
    v_lshl_add_u32 v3, v7, 4, v3
    v_lshlrev_b32 v2, 15, v30
    v_lshl_add_u32 v2, v1, 4, v2
    s_lshr_b32 s3, s2, 1
    s_and_b32 s3, s3, 0x1c
    s_lshr_b32 s3, 0x73625140, s3
    s_lshl_b32 s3, s3, 12
    s_lshl_b32 s13, s8, 2
    s_lshr_b32 s13, 0x76543210, s13
    s_lshl_b32 s13, s13, 12
    s_xor_b32 s3, s3, s13
    s_and_b32 s82, s3, 0x7000
    s_add_u32 s82, s82, s9
    s_mov_b32 s62, 0x800
    s_mov_b32 s63, 0x20000
    s_mov_b32 s54, 0x400000
    s_mov_b32 s55, 0x20000
    s_mov_b32 s46, 0x8000000
    s_mov_b32 s47, 0x20000
    s_lshl1_add_u32 s14, s4, s6
    s_mov_b32 s42, 0
    s_and_b32 s13, s2, 7
    s_or_b32 s13, s13, s8
    s_cselect_b64 vcc, 0, -1
    s_cbranch_scc1 L_npx
    s_bfe_u32 s42, s2, 0x20005
    s_xor_b32 s43, s42, s7
    s_and_b32 s43, s43, 1
    s_lshl1_add_u32 s42, s42, s7
    s_lshl1_add_u32 s43, s14, s43
    s_lshl_b32 s43, s43, 5
    s_add_u32 s43, s43, s42
    s_lshl_b32 s43, s43, 8
    s_add_u32 s43, s43, 0xb0000
    s_lshl3_add_u32 s42, s14, s42
    s_lshl_b32 s42, s42, 3
    s_add_u32 s42, s42, 0xa1000
    s_waitcnt lgkmcnt(0)
    s_memtime s[76:77]
    s_load_dword s43, s[40:41], s43
    s_cmp_eq_u32 s4, 0
    s_branch L_np0
L_npx:
    s_cmp_eq_u32 s4, 0
    s_waitcnt lgkmcnt(0)
L_np0:
    s_cselect_b32 s60, s16, s26
    s_cselect_b32 s61, s17, s27
    s_cselect_b32 s52, s22, s32
    s_cselect_b32 s53, s23, s33
    s_cselect_b32 s44, s18, s28
    s_cselect_b32 s45, s19, s29
    buffer_load_ushort v5, v5, s[60:63], s10 offen
    buffer_load_dwordx4 v[64:67], v3, s[52:55], s11 offen nt
    buffer_load_dwordx4 v[68:71], v2, s[44:47], s82 offen offset:0 nt
    s_cselect_b32 s48, s20, s30
    s_cselect_b32 s49, s21, s31
    s_cselect_b32 s56, s24, s34
    s_cselect_b32 s57, s25, s35
    s_add_u32 s11, s11, 32768
    buffer_load_dwordx4 v[72:75], v3, s[52:55], s11 offen nt
    buffer_load_dwordx4 v[76:79], v2, s[44:47], s82 offen offset:1024 nt
    s_mov_b32 s50, 0x8000000
    s_mov_b32 s51, 0x20000
    s_mov_b32 s58, 0x400000
    s_mov_b32 s59, 0x20000
    s_mov_b32 s66, 0x800000
    s_mov_b32 s67, 0x20000
    s_mov_b32 s70, 0x1000
    s_mov_b32 s71, 0x20000
    s_lshl_b32 s74, s14, 8
    s_add_u32 s74, s74, 0xa0000
    s_mov_b32 s64, s40
    s_mov_b32 s65, s41
    s_mov_b32 s68, s36
    s_mov_b32 s69, s37
    s_cbranch_vccz L_np1
    s_waitcnt lgkmcnt(0)
    s_memtime s[78:79]
    s_waitcnt lgkmcnt(0)
    s_sub_u32 s43, s78, s76
L_np1:
    s_load_dword s72, s[40:41], s74
    s_lshl_b32 s15, s5, 1
    s_or_b32 s15, s15, s7
    s_lshl_b32 s92, s14, 6
    s_add_u32 s92, s92, s15
    s_lshl_b32 s95, s14, 17
    s_lshl_b32 s91, s15, 11
    s_andn2_b32 s91, s5, 3
    s_bfe_u32 s13, s5, 0x10001
    s_or_b32 s91, s91, s13
    s_and_b32 s13, s5, 1
    s_lshl1_add_u32 s91, s13, s91
    s_lshl_b32 s91, s91, 12
    s_add_u32 s91, s91, s95
    s_lshl_b32 s13, s15, 6
    s_add_u32 s95, s95, s13
    v_lshlrev_b32 v61, 2, v0
    v_and_b32 v32, 0x1c3, v0
    v_bfe_u32 v31, v0, 2, 2
    v_lshl_add_u32 v32, v31, 4, v32
    v_bfe_u32 v31, v0, 5, 1
    v_lshl_add_u32 v32, v31, 2, v32
    v_bfe_u32 v31, v0, 4, 1
    v_lshl_add_u32 v32, v31, 3, v32
    v_lshrrev_b32 v58, 4, v32
    v_and_b32 v58, 0x1c, v58
    v_bfe_u32 v31, v32, 5, 1
    v_or_b32 v58, v58, v31
    v_bfe_u32 v31, v32, 4, 1
    v_lshl_or_b32 v58, v31, 1, v58
    v_lshlrev_b32 v58, 12, v58
    v_and_b32 v31, 15, v32
    v_lshl_add_u32 v58, v31, 2, v58
    s_lshr_b32 s94, s92, 1
    s_lshl_b32 s94, s94, 7
    s_add_u32 s94, s94, 0x80000
    v_lshlrev_b32 v62, 3, v7
    s_lshl_b32 s13, s7, 3
    s_add_u32 s13, s13, s8
    s_lshl_b32 s13, s13, 3
    v_mov_b32 v63, s13
    s_lshl_b32 s13, s7, 6
    v_add_u32 v63, s13, v62
    v_mov_b32 v57, 0
    v_mov_b32 v38, 0xfffff000
    s_lshl_b32 s12, s5, 17
    v_lshrrev_b32 v4, 3, v1
    v_lshlrev_b32 v4, 10, v4
    v_lshl_add_u32 v4, v30, 7, v4
    v_and_b32 v31, 7, v0
    v_lshl_add_u32 v4, v31, 4, v4
    v_lshlrev_b32 v34, 12, v30
    v_lshl_add_u32 v35, v6, 10, v34
    v_lshl_add_u32 v35, v7, 5, v35
    v_lshl_add_u32 v34, v1, 4, v34
    v_mul_u32_u24 v60, 288, v30
    v_lshl_add_u32 v60, v7, 3, v60
    v_and_b32 v31, 1, v6
    v_lshl_add_u32 v60, v31, 2, v60
    v_add_u32 v60, 0x2000, v60
    v_mul_u32_u24 v59, 144, v7
    v_lshl_add_u32 v59, v6, 4, v59
    v_and_b32 v39, 1, v0
    v_mul_u32_u24 v39, 0xaaaa, v39
    v_add_u32 v39, 0x4444, v39
    s_mov_b32 s76, 0xcccccccc
    s_mov_b32 s77, 0xcccccccc
    s_mov_b32 s78, 0xaaaaaaaa
    s_mov_b32 s79, 0xaaaaaaaa
    s_mov_b32 s80, 0x3fb8aa3b
    s_mov_b32 s81, 0x3db504f3
    v_mov_b32 v32, 0xffff
    v_mov_b32 v33, 0xffff0000
    v_cndmask_b32 v32, v32, v33, s[78:79]
    v_bfe_u32 v33, v0, 1, 2
    v_cmp_eq_u32 vcc, 0, v33
    s_nop 1
    v_cndmask_b32 v8, 0, v32, vcc
    v_cmp_eq_u32 vcc, 1, v33
    s_nop 1
    v_cndmask_b32 v9, 0, v32, vcc
    v_cmp_eq_u32 vcc, 2, v33
    s_nop 1
    v_cndmask_b32 v10, 0, v32, vcc
    v_cmp_eq_u32 vcc, 3, v33
    s_nop 1
    v_cndmask_b32 v11, 0, v32, vcc
    v_and_b32 v33, 1, v6
    v_lshlrev_b32 v33, 4, v33
    v_lshl_add_u32 v33, v7, 5, v33
    v_lshl_add_u32 v56, v30, 9, v33
    s_lshl_b32 s93, s6, 11
    s_lshl_b32 s13, s4, 10
    s_add_u32 s93, s93, s13
    s_lshl_b32 s13, s15, 4
    s_add_u32 s93, s93, s13
    v_lshlrev_b32 v0, 3, v30
    v_mov_b32 v6, 1
    ds_write_b32 v57, v57 offset:12352
    s_waitcnt vmcnt(4)
    v_lshl_or_b32 v5, v5, 16, v5
    s_nop 1
    v_and_b32_dpp v12, v5, v8 row_newbcast:0 row_mask:0xf bank_mask:0xf
    v_and_b32_dpp v13, v5, v9 row_newbcast:0 row_mask:0xf bank_mask:0xf
    v_and_b32_dpp v14, v5, v10 row_newbcast:0 row_mask:0xf bank_mask:0xf
    v_and_b32_dpp v15, v5, v11 row_newbcast:0 row_mask:0xf bank_mask:0xf
    v_and_b32_dpp v16, v5, v8 row_newbcast:1 row_mask:0xf bank_mask:0xf
    v_and_b32_dpp v17, v5, v9 row_newbcast:1 row_mask:0xf bank_mask:0xf
    v_and_b32_dpp v18, v5, v10 row_newbcast:1 row_mask:0xf bank_mask:0xf
    v_and_b32_dpp v19, v5, v11 row_newbcast:1 row_mask:0xf bank_mask:0xf
    s_waitcnt vmcnt(3)
    v_mfma_f32_16x16x32_bf16 v[20:23], v[12:15], v[64:67], 0
    s_add_u32 s11, s11, 32768
    buffer_load_dwordx4 v[80:83], v3, s[52:55], s11 offen nt
    buffer_load_dwordx4 v[84:87], v2, s[44:47], s82 offen offset:2048 nt
    s_add_u32 s11, s11, 32768
    buffer_load_dwordx4 v[88:91], v3, s[52:55], s11 offen nt
    v_and_b32_dpp v12, v5, v8 row_newbcast:2 row_mask:0xf bank_mask:0xf
    v_and_b32_dpp v13, v5, v9 row_newbcast:2 row_mask:0xf bank_mask:0xf
    v_and_b32_dpp v14, v5, v10 row_newbcast:2 row_mask:0xf bank_mask:0xf
    v_and_b32_dpp v15, v5, v11 row_newbcast:2 row_mask:0xf bank_mask:0xf
    s_waitcnt vmcnt(5)
    buffer_load_dwordx4 v[92:95], v2, s[44:47], s82 offen offset:3072 nt
    s_waitcnt vmcnt(5)
    v_mfma_f32_16x16x32_bf16 v[20:23], v[16:19], v[72:75], v[20:23]
    s_add_u32 s11, s11, 32768
    buffer_load_dwordx4 v[96:99], v3, s[52:55], s11 offen nt
    v_and_b32_dpp v16, v5, v8 row_newbcast:3 row_mask:0xf bank_mask:0xf
    v_and_b32_dpp v17, v5, v9 row_newbcast:3 row_mask:0xf bank_mask:0xf
    v_and_b32_dpp v18, v5, v10 row_newbcast:3 row_mask:0xf bank_mask:0xf
    v_and_b32_dpp v19, v5, v11 row_newbcast:3 row_mask:0xf bank_mask:0xf
    s_waitcnt vmcnt(5)
    s_xor_b32 s3, s3, 0x1000
    s_and_b32 s83, s3, 0x7000
    s_add_u32 s83, s83, s9
    buffer_load_dwordx4 v[100:103], v2, s[44:47], s83 offen offset:0 nt
    s_waitcnt vmcnt(5)
    v_mfma_f32_16x16x32_bf16 v[20:23], v[12:15], v[80:83], v[20:23]
    s_add_u32 s11, s11, 32768
    buffer_load_dwordx4 v[104:107], v3, s[52:55], s11 offen nt
    v_and_b32_dpp v12, v5, v8 row_newbcast:4 row_mask:0xf bank_mask:0xf
    v_and_b32_dpp v13, v5, v9 row_newbcast:4 row_mask:0xf bank_mask:0xf
    v_and_b32_dpp v14, v5, v10 row_newbcast:4 row_mask:0xf bank_mask:0xf
    v_and_b32_dpp v15, v5, v11 row_newbcast:4 row_mask:0xf bank_mask:0xf
    s_waitcnt vmcnt(5)
    buffer_load_dwordx4 v[108:111], v2, s[44:47], s83 offen offset:1024 nt
    s_waitcnt vmcnt(5)
    v_mfma_f32_16x16x32_bf16 v[20:23], v[16:19], v[88:91], v[20:23]
    s_add_u32 s11, s11, 32768
    buffer_load_dwordx4 v[112:115], v3, s[52:55], s11 offen nt
    v_and_b32_dpp v16, v5, v8 row_newbcast:5 row_mask:0xf bank_mask:0xf
    v_and_b32_dpp v17, v5, v9 row_newbcast:5 row_mask:0xf bank_mask:0xf
    v_and_b32_dpp v18, v5, v10 row_newbcast:5 row_mask:0xf bank_mask:0xf
    v_and_b32_dpp v19, v5, v11 row_newbcast:5 row_mask:0xf bank_mask:0xf
    s_waitcnt vmcnt(5)
    buffer_load_dwordx4 v[116:119], v2, s[44:47], s83 offen offset:2048 nt
    s_waitcnt vmcnt(5)
    v_mfma_f32_16x16x32_bf16 v[20:23], v[12:15], v[96:99], v[20:23]
    s_add_u32 s11, s11, 32768
    buffer_load_dwordx4 v[120:123], v3, s[52:55], s11 offen nt
    v_and_b32_dpp v12, v5, v8 row_newbcast:6 row_mask:0xf bank_mask:0xf
    v_and_b32_dpp v13, v5, v9 row_newbcast:6 row_mask:0xf bank_mask:0xf
    v_and_b32_dpp v14, v5, v10 row_newbcast:6 row_mask:0xf bank_mask:0xf
    v_and_b32_dpp v15, v5, v11 row_newbcast:6 row_mask:0xf bank_mask:0xf
    s_waitcnt vmcnt(5)
    buffer_load_dwordx4 v[124:127], v2, s[44:47], s83 offen offset:3072 nt
    s_waitcnt vmcnt(5)
    v_mfma_f32_16x16x32_bf16 v[20:23], v[16:19], v[104:107], v[20:23]
    s_add_u32 s11, s11, 32768
    buffer_load_dwordx4 v[128:131], v3, s[52:55], s11 offen nt
    v_and_b32_dpp v16, v5, v8 row_newbcast:7 row_mask:0xf bank_mask:0xf
    v_and_b32_dpp v17, v5, v9 row_newbcast:7 row_mask:0xf bank_mask:0xf
    v_and_b32_dpp v18, v5, v10 row_newbcast:7 row_mask:0xf bank_mask:0xf
    v_and_b32_dpp v19, v5, v11 row_newbcast:7 row_mask:0xf bank_mask:0xf
    s_waitcnt vmcnt(5)
    s_xor_b32 s3, s3, 0x3000
    s_and_b32 s84, s3, 0x7000
    s_add_u32 s84, s84, s9
    buffer_load_dwordx4 v[132:135], v2, s[44:47], s84 offen offset:0 nt
    s_waitcnt vmcnt(5)
    v_mfma_f32_16x16x32_bf16 v[20:23], v[12:15], v[112:115], v[20:23]
    s_add_u32 s11, s11, 32768
    buffer_load_dwordx4 v[136:139], v3, s[52:55], s11 offen nt
    v_and_b32_dpp v12, v5, v8 row_newbcast:8 row_mask:0xf bank_mask:0xf
    v_and_b32_dpp v13, v5, v9 row_newbcast:8 row_mask:0xf bank_mask:0xf
    v_and_b32_dpp v14, v5, v10 row_newbcast:8 row_mask:0xf bank_mask:0xf
    v_and_b32_dpp v15, v5, v11 row_newbcast:8 row_mask:0xf bank_mask:0xf
    s_waitcnt vmcnt(5)
    buffer_load_dwordx4 v[140:143], v2, s[44:47], s84 offen offset:1024 nt
    s_waitcnt vmcnt(5)
    v_mfma_f32_16x16x32_bf16 v[20:23], v[16:19], v[120:123], v[20:23]
    s_add_u32 s11, s11, 32768
    buffer_load_dwordx4 v[144:147], v3, s[52:55], s11 offen nt
    v_and_b32_dpp v16, v5, v8 row_newbcast:9 row_mask:0xf bank_mask:0xf
    v_and_b32_dpp v17, v5, v9 row_newbcast:9 row_mask:0xf bank_mask:0xf
    v_and_b32_dpp v18, v5, v10 row_newbcast:9 row_mask:0xf bank_mask:0xf
    v_and_b32_dpp v19, v5, v11 row_newbcast:9 row_mask:0xf bank_mask:0xf
    s_waitcnt vmcnt(5)
    buffer_load_dwordx4 v[148:151], v2, s[44:47], s84 offen offset:2048 nt
    s_waitcnt vmcnt(5)
    v_mfma_f32_16x16x32_bf16 v[20:23], v[12:15], v[128:131], v[20:23]
    s_add_u32 s11, s11, 32768
    buffer_load_dwordx4 v[152:155], v3, s[52:55], s11 offen nt
    v_and_b32_dpp v12, v5, v8 row_newbcast:10 row_mask:0xf bank_mask:0xf
    v_and_b32_dpp v13, v5, v9 row_newbcast:10 row_mask:0xf bank_mask:0xf
    v_and_b32_dpp v14, v5, v10 row_newbcast:10 row_mask:0xf bank_mask:0xf
    v_and_b32_dpp v15, v5, v11 row_newbcast:10 row_mask:0xf bank_mask:0xf
    s_waitcnt vmcnt(5)
    buffer_load_dwordx4 v[156:159], v2, s[44:47], s84 offen offset:3072 nt
    s_waitcnt vmcnt(5)
    v_mfma_f32_16x16x32_bf16 v[20:23], v[16:19], v[136:139], v[20:23]
    s_add_u32 s11, s11, 32768
    buffer_load_dwordx4 v[160:163], v3, s[52:55], s11 offen nt
    v_and_b32_dpp v16, v5, v8 row_newbcast:11 row_mask:0xf bank_mask:0xf
    v_and_b32_dpp v17, v5, v9 row_newbcast:11 row_mask:0xf bank_mask:0xf
    v_and_b32_dpp v18, v5, v10 row_newbcast:11 row_mask:0xf bank_mask:0xf
    v_and_b32_dpp v19, v5, v11 row_newbcast:11 row_mask:0xf bank_mask:0xf
    s_waitcnt vmcnt(5)
    s_xor_b32 s3, s3, 0x1000
    s_and_b32 s85, s3, 0x7000
    s_add_u32 s85, s85, s9
    buffer_load_dwordx4 v[164:167], v2, s[44:47], s85 offen offset:0 nt
    s_waitcnt vmcnt(5)
    v_mfma_f32_16x16x32_bf16 v[20:23], v[12:15], v[144:147], v[20:23]
    s_add_u32 s11, s11, 32768
    buffer_load_dwordx4 v[168:171], v3, s[52:55], s11 offen nt
    v_and_b32_dpp v12, v5, v8 row_newbcast:12 row_mask:0xf bank_mask:0xf
    v_and_b32_dpp v13, v5, v9 row_newbcast:12 row_mask:0xf bank_mask:0xf
    v_and_b32_dpp v14, v5, v10 row_newbcast:12 row_mask:0xf bank_mask:0xf
    v_and_b32_dpp v15, v5, v11 row_newbcast:12 row_mask:0xf bank_mask:0xf
    s_waitcnt vmcnt(5)
    buffer_load_dwordx4 v[172:175], v2, s[44:47], s85 offen offset:1024 nt
    s_waitcnt vmcnt(5)
    v_mfma_f32_16x16x32_bf16 v[20:23], v[16:19], v[152:155], v[20:23]
    s_add_u32 s11, s11, 32768
    buffer_load_dwordx4 v[176:179], v3, s[52:55], s11 offen nt
    v_and_b32_dpp v16, v5, v8 row_newbcast:13 row_mask:0xf bank_mask:0xf
    v_and_b32_dpp v17, v5, v9 row_newbcast:13 row_mask:0xf bank_mask:0xf
    v_and_b32_dpp v18, v5, v10 row_newbcast:13 row_mask:0xf bank_mask:0xf
    v_and_b32_dpp v19, v5, v11 row_newbcast:13 row_mask:0xf bank_mask:0xf
    s_waitcnt vmcnt(5)
    buffer_load_dwordx4 v[180:183], v2, s[44:47], s85 offen offset:2048 nt
    s_waitcnt vmcnt(5)
    v_mfma_f32_16x16x32_bf16 v[20:23], v[12:15], v[160:163], v[20:23]
    s_add_u32 s11, s11, 32768
    buffer_load_dwordx4 v[184:187], v3, s[52:55], s11 offen nt
    v_and_b32_dpp v12, v5, v8 row_newbcast:14 row_mask:0xf bank_mask:0xf
    v_and_b32_dpp v13, v5, v9 row_newbcast:14 row_mask:0xf bank_mask:0xf
    v_and_b32_dpp v14, v5, v10 row_newbcast:14 row_mask:0xf bank_mask:0xf
    v_and_b32_dpp v15, v5, v11 row_newbcast:14 row_mask:0xf bank_mask:0xf
    s_waitcnt vmcnt(5)
    buffer_load_dwordx4 v[188:191], v2, s[44:47], s85 offen offset:3072 nt
    s_waitcnt vmcnt(5)
    v_mfma_f32_16x16x32_bf16 v[20:23], v[16:19], v[168:171], v[20:23]
    s_xor_b32 s3, s3, 0x7000
    s_and_b32 s86, s3, 0x7000
    s_add_u32 s86, s86, s9
    buffer_load_dwordx4 v[192:195], v2, s[44:47], s86 offen offset:0 nt
    v_and_b32_dpp v16, v5, v8 row_newbcast:15 row_mask:0xf bank_mask:0xf
    v_and_b32_dpp v17, v5, v9 row_newbcast:15 row_mask:0xf bank_mask:0xf
    v_and_b32_dpp v18, v5, v10 row_newbcast:15 row_mask:0xf bank_mask:0xf
    v_and_b32_dpp v19, v5, v11 row_newbcast:15 row_mask:0xf bank_mask:0xf
    s_waitcnt vmcnt(5)
    buffer_load_dwordx4 v[196:199], v2, s[44:47], s86 offen offset:1024 nt
    s_waitcnt vmcnt(5)
    v_mfma_f32_16x16x32_bf16 v[20:23], v[12:15], v[176:179], v[20:23]
    buffer_load_dwordx4 v[200:203], v2, s[44:47], s86 offen offset:2048 nt
    s_waitcnt vmcnt(5)
    buffer_load_dwordx4 v[204:207], v2, s[44:47], s86 offen offset:3072 nt
    s_waitcnt vmcnt(5)
    v_mfma_f32_16x16x32_bf16 v[20:23], v[16:19], v[184:187], v[20:23]
    s_xor_b32 s3, s3, 0x1000
    s_and_b32 s87, s3, 0x7000
    s_add_u32 s87, s87, s9
    buffer_load_dwordx4 v[208:211], v2, s[44:47], s87 offen offset:0 nt
    s_nop 3
    ds_write_b128 v56, v[20:23]
    v_lshlrev_b32 v30, 3, v1
    v_and_b32 v33, 0x700, v61
    v_lshl_add_u32 v33, v7, 4, v33
    s_waitcnt lgkmcnt(0)
    s_barrier
    ds_read_b64 v[40:41], v30 offset:0
    ds_read_b64 v[42:43], v30 offset:512
    ds_read_b64 v[44:45], v30 offset:1024
    ds_read_b64 v[46:47], v30 offset:1536
    ds_read_b64 v[48:49], v30 offset:2048
    ds_read_b64 v[50:51], v30 offset:2560
    ds_read_b64 v[52:53], v30 offset:3072
    ds_read_b64 v[54:55], v30 offset:3584
    s_add_u32 s97, s72, 1
    s_and_b32 s73, s97, 0xfff
    s_and_b32 s75, s97, 0xffff
    s_waitcnt lgkmcnt(0)
    v_add_f32 v40, v40, v42
    v_add_f32 v41, v41, v43
    v_add_f32 v44, v44, v46
    v_add_f32 v45, v45, v47
    v_add_f32 v48, v48, v50
    v_add_f32 v49, v49, v51
    v_add_f32 v52, v52, v54
    v_add_f32 v53, v53, v55
    v_add_f32 v40, v40, v44
    v_add_f32 v41, v41, v45
    v_add_f32 v48, v48, v52
    v_add_f32 v49, v49, v53
    v_add_f32 v40, v40, v48
    v_add_f32 v41, v41, v49
    v_cvt_pk_bf16_f32 v40, v40, v41
    ds_write_b32 v61, v40 offset:4096
    s_waitcnt lgkmcnt(0)
    ds_read_b128 v[24:27], v33 offset:4096
    s_waitcnt lgkmcnt(0)
    v_mov_b32 v32, s97
    v_mov_b32 v33, s43
    s_cmp_lg_u32 s42, 0
    s_cselect_b64 exec, 0x1, 0
    buffer_store_dwordx2 v[32:33], v62, s[64:67], s42 offen sc1
    s_mov_b64 exec, -1
    s_lshl_b32 s42, s14, 6
    s_add_u32 s42, s42, 0xa1000
    s_or_b32 s43, s7, s8
    s_cselect_b32 s43, 0, 0xff
    v_mov_b32 v40, 0
    v_mov_b32 v41, 0
    v_mov_b32 v42, 0
    v_mov_b32 v43, 0
    v_mov_b32 v44, 0
    v_mov_b32 v45, 0
    v_mov_b32 v46, 0
    v_mov_b32 v47, 0
    v_mov_b32 v48, 0
    v_mov_b32 v49, 0
    v_mov_b32 v50, 0
    v_mov_b32 v51, 0
    v_mov_b32 v52, 0
    v_mov_b32 v53, 0
    v_mov_b32 v54, 0
    v_mov_b32 v55, 0
    v_dot2c_f32_bf16 v40, v68, v24
    v_dot2c_f32_bf16 v40, v69, v25
    v_dot2c_f32_bf16 v40, v70, v26
    v_dot2c_f32_bf16 v40, v71, v27
    v_dot2c_f32_bf16 v41, v76, v24
    v_dot2c_f32_bf16 v41, v77, v25
    v_dot2c_f32_bf16 v41, v78, v26
    v_dot2c_f32_bf16 v41, v79, v27
    v_dot2c_f32_bf16 v42, v84, v24
    v_dot2c_f32_bf16 v42, v85, v25
    v_dot2c_f32_bf16 v42, v86, v26
    v_dot2c_f32_bf16 v42, v87, v27
    v_dot2c_f32_bf16 v43, v92, v24
    v_dot2c_f32_bf16 v43, v93, v25
    v_dot2c_f32_bf16 v43, v94, v26
    v_dot2c_f32_bf16 v43, v95, v27
    v_dot2c_f32_bf16 v44, v100, v24
    v_dot2c_f32_bf16 v44, v101, v25
    v_dot2c_f32_bf16 v44, v102, v26
    v_dot2c_f32_bf16 v44, v103, v27
    v_dot2c_f32_bf16 v45, v108, v24
    v_dot2c_f32_bf16 v45, v109, v25
    v_dot2c_f32_bf16 v45, v110, v26
    v_dot2c_f32_bf16 v45, v111, v27
    s_waitcnt vmcnt(6)
    buffer_load_dwordx4 v[212:215], v2, s[44:47], s87 offen offset:1024 nt
    v_dot2c_f32_bf16 v46, v116, v24
    v_dot2c_f32_bf16 v46, v117, v25
    v_dot2c_f32_bf16 v46, v118, v26
    v_dot2c_f32_bf16 v46, v119, v27
    v_dot2c_f32_bf16 v47, v124, v24
    v_dot2c_f32_bf16 v47, v125, v25
    v_dot2c_f32_bf16 v47, v126, v26
    v_dot2c_f32_bf16 v47, v127, v27
    v_dot2c_f32_bf16 v48, v132, v24
    v_dot2c_f32_bf16 v48, v133, v25
    v_dot2c_f32_bf16 v48, v134, v26
    v_dot2c_f32_bf16 v48, v135, v27
    v_dot2c_f32_bf16 v49, v140, v24
    v_dot2c_f32_bf16 v49, v141, v25
    v_dot2c_f32_bf16 v49, v142, v26
    v_dot2c_f32_bf16 v49, v143, v27
    v_dot2c_f32_bf16 v50, v148, v24
    v_dot2c_f32_bf16 v50, v149, v25
    v_dot2c_f32_bf16 v50, v150, v26
    v_dot2c_f32_bf16 v50, v151, v27
    v_dot2c_f32_bf16 v51, v156, v24
    v_dot2c_f32_bf16 v51, v157, v25
    v_dot2c_f32_bf16 v51, v158, v26
    v_dot2c_f32_bf16 v51, v159, v27
    s_waitcnt vmcnt(6)
    buffer_load_dwordx4 v[216:219], v2, s[44:47], s87 offen offset:2048 nt
    v_dot2c_f32_bf16 v52, v164, v24
    v_dot2c_f32_bf16 v52, v165, v25
    v_dot2c_f32_bf16 v52, v166, v26
    v_dot2c_f32_bf16 v52, v167, v27
    v_dot2c_f32_bf16 v53, v172, v24
    v_dot2c_f32_bf16 v53, v173, v25
    v_dot2c_f32_bf16 v53, v174, v26
    v_dot2c_f32_bf16 v53, v175, v27
    v_dot2c_f32_bf16 v54, v180, v24
    v_dot2c_f32_bf16 v54, v181, v25
    v_dot2c_f32_bf16 v54, v182, v26
    v_dot2c_f32_bf16 v54, v183, v27
    v_dot2c_f32_bf16 v55, v188, v24
    v_dot2c_f32_bf16 v55, v189, v25
    v_dot2c_f32_bf16 v55, v190, v26
    v_dot2c_f32_bf16 v55, v191, v27
    v_add_f32_dpp v40, v40, v40 row_ror:8 row_mask:0xf bank_mask:0x3
    v_add_f32_dpp v41, v41, v41 row_ror:8 row_mask:0xf bank_mask:0x3
    v_add_f32_dpp v42, v42, v42 row_ror:8 row_mask:0xf bank_mask:0x3
    v_add_f32_dpp v43, v43, v43 row_ror:8 row_mask:0xf bank_mask:0x3
    v_add_f32_dpp v44, v44, v44 row_ror:8 row_mask:0xf bank_mask:0x3
    v_add_f32_dpp v45, v45, v45 row_ror:8 row_mask:0xf bank_mask:0x3
    v_add_f32_dpp v46, v46, v46 row_ror:8 row_mask:0xf bank_mask:0x3
    v_add_f32_dpp v47, v47, v47 row_ror:8 row_mask:0xf bank_mask:0x3
    v_add_f32_dpp v40, v48, v48 row_ror:8 row_mask:0xf bank_mask:0xc
    v_add_f32_dpp v41, v49, v49 row_ror:8 row_mask:0xf bank_mask:0xc
    v_add_f32_dpp v42, v50, v50 row_ror:8 row_mask:0xf bank_mask:0xc
    v_add_f32_dpp v43, v51, v51 row_ror:8 row_mask:0xf bank_mask:0xc
    v_add_f32_dpp v44, v52, v52 row_ror:8 row_mask:0xf bank_mask:0xc
    v_add_f32_dpp v45, v53, v53 row_ror:8 row_mask:0xf bank_mask:0xc
    v_add_f32_dpp v46, v54, v54 row_ror:8 row_mask:0xf bank_mask:0xc
    v_add_f32_dpp v47, v55, v55 row_ror:8 row_mask:0xf bank_mask:0xc
    v_add_f32_dpp v40, v40, v40 row_half_mirror row_mask:0xf bank_mask:0x5
    v_add_f32_dpp v41, v41, v41 row_half_mirror row_mask:0xf bank_mask:0x5
    v_add_f32_dpp v42, v42, v42 row_half_mirror row_mask:0xf bank_mask:0x5
    v_add_f32_dpp v43, v43, v43 row_half_mirror row_mask:0xf bank_mask:0x5
    v_add_f32_dpp v40, v44, v44 row_half_mirror row_mask:0xf bank_mask:0xa
    v_add_f32_dpp v41, v45, v45 row_half_mirror row_mask:0xf bank_mask:0xa
    v_add_f32_dpp v42, v46, v46 row_half_mirror row_mask:0xf bank_mask:0xa
    v_add_f32_dpp v43, v47, v47 row_half_mirror row_mask:0xf bank_mask:0xa
    v_add_f32_dpp v40, v40, v40 quad_perm:[2,3,0,1] row_mask:0xf bank_mask:0xf
    v_add_f32_dpp v41, v41, v41 quad_perm:[2,3,0,1] row_mask:0xf bank_mask:0xf
    v_add_f32_dpp v42, v42, v42 quad_perm:[2,3,0,1] row_mask:0xf bank_mask:0xf
    v_add_f32_dpp v43, v43, v43 quad_perm:[2,3,0,1] row_mask:0xf bank_mask:0xf
    v_cndmask_b32 v40, v40, v42, s[76:77]
    v_cndmask_b32 v41, v41, v43, s[76:77]
    s_nop 0
    v_add_f32_dpp v40, v40, v40 quad_perm:[1,0,3,2] row_mask:0xf bank_mask:0xf
    v_add_f32_dpp v41, v41, v41 quad_perm:[1,0,3,2] row_mask:0xf bank_mask:0xf
    v_cndmask_b32 v28, v40, v41, s[78:79]
    v_cvt_pk_bf16_f32 v28, v28, v28
    v_and_b32 v28, 0xffff0000, v28
    v_mul_f32 v28, s81, v28
    v_cvt_pk_bf16_f32 v28, v28, v28
    v_and_b32 v28, 0xffff0000, v28
    v_mov_b32 v40, 0
    v_mov_b32 v41, 0
    v_mov_b32 v42, 0
    v_mov_b32 v43, 0
    v_mov_b32 v44, 0
    v_mov_b32 v45, 0
    v_mov_b32 v46, 0
    v_mov_b32 v47, 0
    v_mov_b32 v48, 0
    v_mov_b32 v49, 0
    v_mov_b32 v50, 0
    v_mov_b32 v51, 0
    v_mov_b32 v52, 0
    v_mov_b32 v53, 0
    v_mov_b32 v54, 0
    v_mov_b32 v55, 0
    v_dot2c_f32_bf16 v40, v192, v24
    v_dot2c_f32_bf16 v40, v193, v25
    v_dot2c_f32_bf16 v40, v194, v26
    v_dot2c_f32_bf16 v40, v195, v27
    s_waitcnt vmcnt(6)
    v_dot2c_f32_bf16 v41, v196, v24
    v_dot2c_f32_bf16 v41, v197, v25
    v_dot2c_f32_bf16 v41, v198, v26
    v_dot2c_f32_bf16 v41, v199, v27
    buffer_load_dwordx4 v[220:223], v2, s[44:47], s87 offen offset:3072 nt
    s_waitcnt vmcnt(6)
    v_dot2c_f32_bf16 v42, v200, v24
    v_dot2c_f32_bf16 v42, v201, v25
    v_dot2c_f32_bf16 v42, v202, v26
    v_dot2c_f32_bf16 v42, v203, v27
    s_xor_b32 s3, s3, 0x3000
    s_and_b32 s88, s3, 0x7000
    s_add_u32 s88, s88, s9
    buffer_load_dwordx4 v[224:227], v2, s[44:47], s88 offen offset:0 nt
    s_waitcnt vmcnt(6)
    v_dot2c_f32_bf16 v43, v204, v24
    v_dot2c_f32_bf16 v43, v205, v25
    v_dot2c_f32_bf16 v43, v206, v26
    v_dot2c_f32_bf16 v43, v207, v27
    buffer_load_dwordx4 v[228:231], v2, s[44:47], s88 offen offset:1024 nt
    s_waitcnt vmcnt(6)
    v_dot2c_f32_bf16 v44, v208, v24
    v_dot2c_f32_bf16 v44, v209, v25
    v_dot2c_f32_bf16 v44, v210, v26
    v_dot2c_f32_bf16 v44, v211, v27
    buffer_load_dwordx4 v[232:235], v2, s[44:47], s88 offen offset:2048 nt
    s_waitcnt vmcnt(5)
    v_dot2c_f32_bf16 v45, v212, v24
    v_dot2c_f32_bf16 v45, v213, v25
    v_dot2c_f32_bf16 v45, v214, v26
    v_dot2c_f32_bf16 v45, v215, v27
    buffer_load_dwordx4 v[236:239], v2, s[44:47], s88 offen offset:3072 nt
    s_waitcnt vmcnt(5)
    v_dot2c_f32_bf16 v46, v216, v24
    v_dot2c_f32_bf16 v46, v217, v25
    v_dot2c_f32_bf16 v46, v218, v26
    v_dot2c_f32_bf16 v46, v219, v27
    s_xor_b32 s3, s3, 0x1000
    s_and_b32 s89, s3, 0x7000
    s_add_u32 s89, s89, s9
    buffer_load_dwordx4 v[240:243], v2, s[44:47], s89 offen offset:0 nt
    s_waitcnt vmcnt(5)
    v_dot2c_f32_bf16 v47, v220, v24
    v_dot2c_f32_bf16 v47, v221, v25
    v_dot2c_f32_bf16 v47, v222, v26
    v_dot2c_f32_bf16 v47, v223, v27
    buffer_load_dwordx4 v[244:247], v2, s[44:47], s89 offen offset:1024 nt
    s_waitcnt vmcnt(5)
    v_dot2c_f32_bf16 v48, v224, v24
    v_dot2c_f32_bf16 v48, v225, v25
    v_dot2c_f32_bf16 v48, v226, v26
    v_dot2c_f32_bf16 v48, v227, v27
    buffer_load_dwordx4 v[248:251], v2, s[44:47], s89 offen offset:2048 nt
    s_waitcnt vmcnt(5)
    v_dot2c_f32_bf16 v49, v228, v24
    v_dot2c_f32_bf16 v49, v229, v25
    v_dot2c_f32_bf16 v49, v230, v26
    v_dot2c_f32_bf16 v49, v231, v27
    buffer_load_dwordx4 v[252:255], v2, s[44:47], s89 offen offset:3072 nt
    s_waitcnt vmcnt(5)
    v_dot2c_f32_bf16 v50, v232, v24
    v_dot2c_f32_bf16 v50, v233, v25
    v_dot2c_f32_bf16 v50, v234, v26
    v_dot2c_f32_bf16 v50, v235, v27
    buffer_load_dwordx4 v[64:67], v4, s[56:59], s12 offen nt
    s_waitcnt vmcnt(5)
    v_dot2c_f32_bf16 v51, v236, v24
    v_dot2c_f32_bf16 v51, v237, v25
    v_dot2c_f32_bf16 v51, v238, v26
    v_dot2c_f32_bf16 v51, v239, v27
    buffer_load_dwordx4 v[72:75], v2, s[48:51], s82 offen offset:0 nt
    s_waitcnt vmcnt(5)
    v_dot2c_f32_bf16 v52, v240, v24
    v_dot2c_f32_bf16 v52, v241, v25
    v_dot2c_f32_bf16 v52, v242, v26
    v_dot2c_f32_bf16 v52, v243, v27
    s_add_u32 s12, s12, 8192
    buffer_load_dwordx4 v[80:83], v4, s[56:59], s12 offen nt
    s_waitcnt vmcnt(5)
    v_dot2c_f32_bf16 v53, v244, v24
    v_dot2c_f32_bf16 v53, v245, v25
    v_dot2c_f32_bf16 v53, v246, v26
    v_dot2c_f32_bf16 v53, v247, v27
    buffer_load_dwordx4 v[88:91], v2, s[48:51], s82 offen offset:1024 nt
    s_waitcnt vmcnt(5)
    v_dot2c_f32_bf16 v54, v248, v24
    v_dot2c_f32_bf16 v54, v249, v25
    v_dot2c_f32_bf16 v54, v250, v26
    v_dot2c_f32_bf16 v54, v251, v27
    s_add_u32 s12, s12, 8192
    buffer_load_dwordx4 v[96:99], v4, s[56:59], s12 offen nt
    s_waitcnt vmcnt(5)
    v_dot2c_f32_bf16 v55, v252, v24
    v_dot2c_f32_bf16 v55, v253, v25
    v_dot2c_f32_bf16 v55, v254, v26
    v_dot2c_f32_bf16 v55, v255, v27
    buffer_load_dwordx4 v[104:107], v2, s[48:51], s82 offen offset:2048 nt
    v_add_f32_dpp v40, v40, v40 row_ror:8 row_mask:0xf bank_mask:0x3
    v_add_f32_dpp v41, v41, v41 row_ror:8 row_mask:0xf bank_mask:0x3
    v_add_f32_dpp v42, v42, v42 row_ror:8 row_mask:0xf bank_mask:0x3
    v_add_f32_dpp v43, v43, v43 row_ror:8 row_mask:0xf bank_mask:0x3
    v_add_f32_dpp v44, v44, v44 row_ror:8 row_mask:0xf bank_mask:0x3
    v_add_f32_dpp v45, v45, v45 row_ror:8 row_mask:0xf bank_mask:0x3
    v_add_f32_dpp v46, v46, v46 row_ror:8 row_mask:0xf bank_mask:0x3
    v_add_f32_dpp v47, v47, v47 row_ror:8 row_mask:0xf bank_mask:0x3
    v_add_f32_dpp v40, v48, v48 row_ror:8 row_mask:0xf bank_mask:0xc
    v_add_f32_dpp v41, v49, v49 row_ror:8 row_mask:0xf bank_mask:0xc
    v_add_f32_dpp v42, v50, v50 row_ror:8 row_mask:0xf bank_mask:0xc
    v_add_f32_dpp v43, v51, v51 row_ror:8 row_mask:0xf bank_mask:0xc
    v_add_f32_dpp v44, v52, v52 row_ror:8 row_mask:0xf bank_mask:0xc
    v_add_f32_dpp v45, v53, v53 row_ror:8 row_mask:0xf bank_mask:0xc
    v_add_f32_dpp v46, v54, v54 row_ror:8 row_mask:0xf bank_mask:0xc
    v_add_f32_dpp v47, v55, v55 row_ror:8 row_mask:0xf bank_mask:0xc
    v_add_f32_dpp v40, v40, v40 row_half_mirror row_mask:0xf bank_mask:0x5
    v_add_f32_dpp v41, v41, v41 row_half_mirror row_mask:0xf bank_mask:0x5
    v_add_f32_dpp v42, v42, v42 row_half_mirror row_mask:0xf bank_mask:0x5
    v_add_f32_dpp v43, v43, v43 row_half_mirror row_mask:0xf bank_mask:0x5
    v_add_f32_dpp v40, v44, v44 row_half_mirror row_mask:0xf bank_mask:0xa
    v_add_f32_dpp v41, v45, v45 row_half_mirror row_mask:0xf bank_mask:0xa
    v_add_f32_dpp v42, v46, v46 row_half_mirror row_mask:0xf bank_mask:0xa
    v_add_f32_dpp v43, v47, v47 row_half_mirror row_mask:0xf bank_mask:0xa
    v_add_f32_dpp v40, v40, v40 quad_perm:[2,3,0,1] row_mask:0xf bank_mask:0xf
    v_add_f32_dpp v41, v41, v41 quad_perm:[2,3,0,1] row_mask:0xf bank_mask:0xf
    v_add_f32_dpp v42, v42, v42 quad_perm:[2,3,0,1] row_mask:0xf bank_mask:0xf
    v_add_f32_dpp v43, v43, v43 quad_perm:[2,3,0,1] row_mask:0xf bank_mask:0xf
    v_cndmask_b32 v40, v40, v42, s[76:77]
    v_cndmask_b32 v41, v41, v43, s[76:77]
    s_nop 0
    v_add_f32_dpp v40, v40, v40 quad_perm:[1,0,3,2] row_mask:0xf bank_mask:0xf
    v_add_f32_dpp v41, v41, v41 quad_perm:[1,0,3,2] row_mask:0xf bank_mask:0xf
    v_cndmask_b32 v29, v40, v41, s[78:79]
    v_cvt_pk_bf16_f32 v29, v29, v29
    v_and_b32 v29, 0xffff0000, v29
    v_mul_f32 v29, s81, v29
    v_cvt_pk_bf16_f32 v29, v29, v29
    v_and_b32 v29, 0xffff0000, v29
    v_max_f32 v30, v28, v29
    s_nop 1
    v_max_f32_dpp v30, v30, v30 row_ror:8 row_mask:0xf bank_mask:0xf
    s_nop 1
    v_max_f32_dpp v30, v30, v30 row_ror:4 row_mask:0xf bank_mask:0xf
    s_nop 1
    v_max_f32_dpp v30, v30, v30 row_ror:2 row_mask:0xf bank_mask:0xf
    s_nop 1
    v_max_f32_dpp v30, v30, v30 row_ror:1 row_mask:0xf bank_mask:0xf
    s_nop 1
    v_max_f32_dpp v30, v30, v30 row_bcast:15 row_mask:0xa bank_mask:0xf
    s_nop 1
    v_max_f32_dpp v30, v30, v30 row_bcast:31 row_mask:0xc bank_mask:0xf
    s_nop 0
    v_readlane_b32 s96, v30, 63
    s_nop 1
    v_subrev_f32 v28, s96, v28
    v_subrev_f32 v29, s96, v29
    v_mul_f32 v28, s80, v28
    v_mul_f32 v29, s80, v29
    v_exp_f32 v28, v28
    v_exp_f32 v29, v29
    s_nop 0
    v_add_f32 v31, v28, v29
    v_cvt_pk_bf16_f32 v28, v28, v28
    v_cvt_pk_bf16_f32 v29, v29, v29
    s_nop 0
    v_and_b32_dpp v12, v28, v8 row_newbcast:0 row_mask:0xf bank_mask:0xf
    v_and_b32_dpp v13, v28, v9 row_newbcast:0 row_mask:0xf bank_mask:0xf
    v_and_b32_dpp v14, v28, v10 row_newbcast:0 row_mask:0xf bank_mask:0xf
    v_and_b32_dpp v15, v28, v11 row_newbcast:0 row_mask:0xf bank_mask:0xf
    v_and_b32_dpp v16, v28, v8 row_newbcast:1 row_mask:0xf bank_mask:0xf
    v_and_b32_dpp v17, v28, v9 row_newbcast:1 row_mask:0xf bank_mask:0xf
    v_and_b32_dpp v18, v28, v10 row_newbcast:1 row_mask:0xf bank_mask:0xf
    v_and_b32_dpp v19, v28, v11 row_newbcast:1 row_mask:0xf bank_mask:0xf
    s_waitcnt vmcnt(5)
    s_add_u32 s12, s12, 8192
    buffer_load_dwordx4 v[112:115], v4, s[56:59], s12 offen nt
    s_waitcnt vmcnt(5)
    v_mfma_f32_16x16x32_bf16 v[20:23], v[12:15], v[72:75], 0
    buffer_load_dwordx4 v[120:123], v2, s[48:51], s82 offen offset:3072 nt
    ds_write_b128 v34, v[64:67] offset:16384
    v_add_f32_dpp v31, v31, v31 row_ror:8 row_mask:0xf bank_mask:0xf
    v_and_b32_dpp v12, v28, v8 row_newbcast:2 row_mask:0xf bank_mask:0xf
    v_and_b32_dpp v13, v28, v9 row_newbcast:2 row_mask:0xf bank_mask:0xf
    v_and_b32_dpp v14, v28, v10 row_newbcast:2 row_mask:0xf bank_mask:0xf
    v_and_b32_dpp v15, v28, v11 row_newbcast:2 row_mask:0xf bank_mask:0xf
    s_waitcnt vmcnt(5)
    s_add_u32 s12, s12, 8192
    buffer_load_dwordx4 v[68:71], v4, s[56:59], s12 offen nt
    s_waitcnt vmcnt(5)
    v_mfma_f32_16x16x32_bf16 v[20:23], v[16:19], v[88:91], v[20:23]
    buffer_load_dwordx4 v[128:131], v2, s[48:51], s83 offen offset:0 nt
    ds_write_b128 v34, v[80:83] offset:17408
    v_add_f32_dpp v31, v31, v31 row_ror:4 row_mask:0xf bank_mask:0xf
    v_and_b32_dpp v16, v28, v8 row_newbcast:3 row_mask:0xf bank_mask:0xf
    v_and_b32_dpp v17, v28, v9 row_newbcast:3 row_mask:0xf bank_mask:0xf
    v_and_b32_dpp v18, v28, v10 row_newbcast:3 row_mask:0xf bank_mask:0xf
    v_and_b32_dpp v19, v28, v11 row_newbcast:3 row_mask:0xf bank_mask:0xf
    s_waitcnt vmcnt(5)
    s_add_u32 s12, s12, 8192
    buffer_load_dwordx4 v[84:87], v4, s[56:59], s12 offen nt
    s_waitcnt vmcnt(5)
    v_mfma_f32_16x16x32_bf16 v[20:23], v[12:15], v[104:107], v[20:23]
    buffer_load_dwordx4 v[136:139], v2, s[48:51], s83 offen offset:1024 nt
    ds_write_b128 v34, v[96:99] offset:18432
    v_add_f32_dpp v31, v31, v31 row_ror:2 row_mask:0xf bank_mask:0xf
    v_and_b32_dpp v12, v28, v8 row_newbcast:4 row_mask:0xf bank_mask:0xf
    v_and_b32_dpp v13, v28, v9 row_newbcast:4 row_mask:0xf bank_mask:0xf
    v_and_b32_dpp v14, v28, v10 row_newbcast:4 row_mask:0xf bank_mask:0xf
    v_and_b32_dpp v15, v28, v11 row_newbcast:4 row_mask:0xf bank_mask:0xf
    s_waitcnt vmcnt(5)
    s_add_u32 s12, s12, 8192
    buffer_load_dwordx4 v[100:103], v4, s[56:59], s12 offen nt
    s_waitcnt vmcnt(5)
    v_mfma_f32_16x16x32_bf16 v[20:23], v[16:19], v[120:123], v[20:23]
    buffer_load_dwordx4 v[144:147], v2, s[48:51], s83 offen offset:2048 nt
    ds_write_b128 v34, v[112:115] offset:19456
    ds_read_b64_tr_b16 v[64:65], v35 offset:16384
    ds_read_b64_tr_b16 v[66:67], v35 offset:16896
    ds_read_b64_tr_b16 v[80:81], v35 offset:16392
    ds_read_b64_tr_b16 v[82:83], v35 offset:16904
    ds_read_b64_tr_b16 v[96:97], v35 offset:16400
    ds_read_b64_tr_b16 v[98:99], v35 offset:16912
    ds_read_b64_tr_b16 v[112:113], v35 offset:16408
    ds_read_b64_tr_b16 v[114:115], v35 offset:16920
    v_add_f32_dpp v31, v31, v31 row_ror:1 row_mask:0xf bank_mask:0xf
    v_and_b32_dpp v16, v28, v8 row_newbcast:5 row_mask:0xf bank_mask:0xf
    v_and_b32_dpp v17, v28, v9 row_newbcast:5 row_mask:0xf bank_mask:0xf
    v_and_b32_dpp v18, v28, v10 row_newbcast:5 row_mask:0xf bank_mask:0xf
    v_and_b32_dpp v19, v28, v11 row_newbcast:5 row_mask:0xf bank_mask:0xf
    s_waitcnt vmcnt(5)
    s_add_u32 s12, s12, 8192
    buffer_load_dwordx4 v[116:119], v4, s[56:59], s12 offen nt
    s_waitcnt vmcnt(5)
    v_mfma_f32_16x16x32_bf16 v[20:23], v[12:15], v[128:131], v[20:23]
    buffer_load_dwordx4 v[152:155], v2, s[48:51], s83 offen offset:3072 nt
    ds_write_b128 v34, v[68:71] offset:16384
    v_add_f32_dpp v31, v31, v31 row_bcast:15 row_mask:0xa bank_mask:0xf
    v_and_b32_dpp v12, v28, v8 row_newbcast:6 row_mask:0xf bank_mask:0xf
    v_and_b32_dpp v13, v28, v9 row_newbcast:6 row_mask:0xf bank_mask:0xf
    v_and_b32_dpp v14, v28, v10 row_newbcast:6 row_mask:0xf bank_mask:0xf
    v_and_b32_dpp v15, v28, v11 row_newbcast:6 row_mask:0xf bank_mask:0xf
    s_waitcnt vmcnt(5)
    s_add_u32 s12, s12, 8192
    buffer_load_dwordx4 v[160:163], v4, s[56:59], s12 offen nt
    s_waitcnt vmcnt(5)
    v_mfma_f32_16x16x32_bf16 v[20:23], v[16:19], v[136:139], v[20:23]
    buffer_load_dwordx4 v[168:171], v2, s[48:51], s84 offen offset:0 nt
    ds_write_b128 v34, v[84:87] offset:17408
    v_add_f32_dpp v31, v31, v31 row_bcast:31 row_mask:0xc bank_mask:0xf
    v_and_b32_dpp v16, v28, v8 row_newbcast:7 row_mask:0xf bank_mask:0xf
    v_and_b32_dpp v17, v28, v9 row_newbcast:7 row_mask:0xf bank_mask:0xf
    v_and_b32_dpp v18, v28, v10 row_newbcast:7 row_mask:0xf bank_mask:0xf
    v_and_b32_dpp v19, v28, v11 row_newbcast:7 row_mask:0xf bank_mask:0xf
    s_waitcnt vmcnt(5)
    s_add_u32 s12, s12, 8192
    buffer_load_dwordx4 v[176:179], v4, s[56:59], s12 offen nt
    s_waitcnt vmcnt(5)
    v_mfma_f32_16x16x32_bf16 v[20:23], v[12:15], v[144:147], v[20:23]
    buffer_load_dwordx4 v[184:187], v2, s[48:51], s84 offen offset:1024 nt
    ds_write_b128 v34, v[100:103] offset:18432
    v_or_b32 v30, s75, v30
    v_and_b32_dpp v12, v28, v8 row_newbcast:8 row_mask:0xf bank_mask:0xf
    v_and_b32_dpp v13, v28, v9 row_newbcast:8 row_mask:0xf bank_mask:0xf
    v_and_b32_dpp v14, v28, v10 row_newbcast:8 row_mask:0xf bank_mask:0xf
    v_and_b32_dpp v15, v28, v11 row_newbcast:8 row_mask:0xf bank_mask:0xf
    s_waitcnt vmcnt(5)
    s_add_u32 s12, s12, 8192
    buffer_load_dwordx4 v[124:127], v4, s[56:59], s12 offen nt
    s_waitcnt vmcnt(5)
    v_mfma_f32_16x16x32_bf16 v[20:23], v[16:19], v[152:155], v[20:23]
    buffer_load_dwordx4 v[76:79], v2, s[48:51], s84 offen offset:2048 nt
    ds_write_b128 v34, v[116:119] offset:19456
    ds_read_b64_tr_b16 v[68:69], v35 offset:16384
    ds_read_b64_tr_b16 v[70:71], v35 offset:16896
    ds_read_b64_tr_b16 v[84:85], v35 offset:16392
    ds_read_b64_tr_b16 v[86:87], v35 offset:16904
    ds_read_b64_tr_b16 v[100:101], v35 offset:16400
    ds_read_b64_tr_b16 v[102:103], v35 offset:16912
    ds_read_b64_tr_b16 v[116:117], v35 offset:16408
    ds_read_b64_tr_b16 v[118:119], v35 offset:16920
    v_and_or_b32 v31, v31, v38, s73
    s_mov_b32 exec_lo, 0
    s_mov_b32 exec_hi, 0x80000000
    ds_write_b64 v0, v[30:31] offset:12288
    ds_add_rtn_u32 v6, v57, v6 offset:12352
    s_mov_b64 exec, -1
    ds_read_b64 v[30:31], v62 offset:12288
    v_and_b32_dpp v16, v28, v8 row_newbcast:9 row_mask:0xf bank_mask:0xf
    v_and_b32_dpp v17, v28, v9 row_newbcast:9 row_mask:0xf bank_mask:0xf
    v_and_b32_dpp v18, v28, v10 row_newbcast:9 row_mask:0xf bank_mask:0xf
    v_and_b32_dpp v19, v28, v11 row_newbcast:9 row_mask:0xf bank_mask:0xf
    s_waitcnt vmcnt(5)
    s_add_u32 s12, s12, 8192
    buffer_load_dwordx4 v[132:135], v4, s[56:59], s12 offen nt
    s_waitcnt vmcnt(5)
    v_mfma_f32_16x16x32_bf16 v[20:23], v[12:15], v[168:171], v[20:23]
    buffer_load_dwordx4 v[92:95], v2, s[48:51], s84 offen offset:3072 nt
    ds_write_b128 v34, v[160:163] offset:16384
    s_waitcnt lgkmcnt(0)
    v_readlane_b32 s13, v6, 63
    s_nop 0
    s_cmp_eq_u32 s13, 7
    s_cselect_b64 exec, 0xff, 0
    buffer_store_dwordx2 v[30:31], v63, s[64:67], s94 offen sc1
    s_mov_b64 exec, -1
    v_and_b32_dpp v12, v28, v8 row_newbcast:10 row_mask:0xf bank_mask:0xf
    v_and_b32_dpp v13, v28, v9 row_newbcast:10 row_mask:0xf bank_mask:0xf
    v_and_b32_dpp v14, v28, v10 row_newbcast:10 row_mask:0xf bank_mask:0xf
    v_and_b32_dpp v15, v28, v11 row_newbcast:10 row_mask:0xf bank_mask:0xf
    s_waitcnt vmcnt(6)
    s_add_u32 s12, s12, 8192
    buffer_load_dwordx4 v[164:167], v4, s[56:59], s12 offen nt
    s_waitcnt vmcnt(6)
    v_mfma_f32_16x16x32_bf16 v[20:23], v[16:19], v[184:187], v[20:23]
    buffer_load_dwordx4 v[108:111], v2, s[48:51], s85 offen offset:0 nt
    ds_write_b128 v34, v[176:179] offset:17408
    v_and_b32_dpp v16, v28, v8 row_newbcast:11 row_mask:0xf bank_mask:0xf
    v_and_b32_dpp v17, v28, v9 row_newbcast:11 row_mask:0xf bank_mask:0xf
    v_and_b32_dpp v18, v28, v10 row_newbcast:11 row_mask:0xf bank_mask:0xf
    v_and_b32_dpp v19, v28, v11 row_newbcast:11 row_mask:0xf bank_mask:0xf
    s_waitcnt vmcnt(6)
    s_add_u32 s12, s12, 8192
    buffer_load_dwordx4 v[180:183], v4, s[56:59], s12 offen nt
    s_waitcnt vmcnt(6)
    v_mfma_f32_16x16x32_bf16 v[20:23], v[12:15], v[76:79], v[20:23]
    buffer_load_dwordx4 v[140:143], v2, s[48:51], s85 offen offset:1024 nt
    ds_write_b128 v34, v[124:127] offset:18432
    v_and_b32_dpp v12, v28, v8 row_newbcast:12 row_mask:0xf bank_mask:0xf
    v_and_b32_dpp v13, v28, v9 row_newbcast:12 row_mask:0xf bank_mask:0xf
    v_and_b32_dpp v14, v28, v10 row_newbcast:12 row_mask:0xf bank_mask:0xf
    v_and_b32_dpp v15, v28, v11 row_newbcast:12 row_mask:0xf bank_mask:0xf
    s_waitcnt vmcnt(6)
    s_add_u32 s12, s12, 8192
    buffer_load_dwordx4 v[128:131], v4, s[56:59], s12 offen nt
    s_waitcnt vmcnt(6)
    v_mfma_f32_16x16x32_bf16 v[20:23], v[16:19], v[92:95], v[20:23]
    buffer_load_dwordx4 v[148:151], v2, s[48:51], s85 offen offset:2048 nt
    ds_write_b128 v34, v[132:135] offset:19456
    ds_read_b64_tr_b16 v[160:161], v35 offset:16384
    ds_read_b64_tr_b16 v[162:163], v35 offset:16896
    ds_read_b64_tr_b16 v[176:177], v35 offset:16392
    ds_read_b64_tr_b16 v[178:179], v35 offset:16904
    ds_read_b64_tr_b16 v[124:125], v35 offset:16400
    ds_read_b64_tr_b16 v[126:127], v35 offset:16912
    ds_read_b64_tr_b16 v[132:133], v35 offset:16408
    ds_read_b64_tr_b16 v[134:135], v35 offset:16920
    v_and_b32_dpp v16, v28, v8 row_newbcast:13 row_mask:0xf bank_mask:0xf
    v_and_b32_dpp v17, v28, v9 row_newbcast:13 row_mask:0xf bank_mask:0xf
    v_and_b32_dpp v18, v28, v10 row_newbcast:13 row_mask:0xf bank_mask:0xf
    v_and_b32_dpp v19, v28, v11 row_newbcast:13 row_mask:0xf bank_mask:0xf
    s_waitcnt vmcnt(5)
    s_add_u32 s12, s12, 8192
    buffer_load_dwordx4 v[136:139], v4, s[56:59], s12 offen nt
    s_waitcnt vmcnt(5)
    v_mfma_f32_16x16x32_bf16 v[20:23], v[12:15], v[108:111], v[20:23]
    buffer_load_dwordx4 v[156:159], v2, s[48:51], s85 offen offset:3072 nt
    ds_write_b128 v34, v[164:167] offset:16384
    v_and_b32_dpp v12, v28, v8 row_newbcast:14 row_mask:0xf bank_mask:0xf
    v_and_b32_dpp v13, v28, v9 row_newbcast:14 row_mask:0xf bank_mask:0xf
    v_and_b32_dpp v14, v28, v10 row_newbcast:14 row_mask:0xf bank_mask:0xf
    v_and_b32_dpp v15, v28, v11 row_newbcast:14 row_mask:0xf bank_mask:0xf
    s_waitcnt vmcnt(5)
    buffer_load_dwordx4 v[172:175], v2, s[48:51], s86 offen offset:0 nt
    s_waitcnt vmcnt(5)
    v_mfma_f32_16x16x32_bf16 v[20:23], v[16:19], v[140:143], v[20:23]
    buffer_load_dwordx4 v[188:191], v2, s[48:51], s86 offen offset:1024 nt
    ds_write_b128 v34, v[180:183] offset:17408
    v_and_b32_dpp v16, v28, v8 row_newbcast:15 row_mask:0xf bank_mask:0xf
    v_and_b32_dpp v17, v28, v9 row_newbcast:15 row_mask:0xf bank_mask:0xf
    v_and_b32_dpp v18, v28, v10 row_newbcast:15 row_mask:0xf bank_mask:0xf
    v_and_b32_dpp v19, v28, v11 row_newbcast:15 row_mask:0xf bank_mask:0xf
    s_waitcnt vmcnt(5)
    buffer_load_dwordx4 v[192:195], v2, s[48:51], s86 offen offset:2048 nt
    s_waitcnt vmcnt(5)
    v_mfma_f32_16x16x32_bf16 v[20:23], v[12:15], v[148:151], v[20:23]
    buffer_load_dwordx4 v[196:199], v2, s[48:51], s86 offen offset:3072 nt
    ds_write_b128 v34, v[128:131] offset:18432
    s_waitcnt vmcnt(5)
    buffer_load_dwordx4 v[200:203], v2, s[48:51], s87 offen offset:0 nt
    s_waitcnt vmcnt(5)
    v_mfma_f32_16x16x32_bf16 v[20:23], v[16:19], v[156:159], v[20:23]
    buffer_load_dwordx4 v[204:207], v2, s[48:51], s87 offen offset:1024 nt
    buffer_load_dwordx2 v[36:37], v62, s[64:67], s94 offen sc1 nt
    ds_write_b128 v34, v[136:139] offset:19456
    ds_read_b64_tr_b16 v[164:165], v35 offset:16384
    ds_read_b64_tr_b16 v[166:167], v35 offset:16896
    ds_read_b64_tr_b16 v[180:181], v35 offset:16392
    ds_read_b64_tr_b16 v[182:183], v35 offset:16904
    ds_read_b64_tr_b16 v[128:129], v35 offset:16400
    ds_read_b64_tr_b16 v[130:131], v35 offset:16912
    ds_read_b64_tr_b16 v[136:137], v35 offset:16408
    ds_read_b64_tr_b16 v[138:139], v35 offset:16920
    v_and_b32_dpp v12, v29, v8 row_newbcast:0 row_mask:0xf bank_mask:0xf
    v_and_b32_dpp v13, v29, v9 row_newbcast:0 row_mask:0xf bank_mask:0xf
    v_and_b32_dpp v14, v29, v10 row_newbcast:0 row_mask:0xf bank_mask:0xf
    v_and_b32_dpp v15, v29, v11 row_newbcast:0 row_mask:0xf bank_mask:0xf
    v_and_b32_dpp v16, v29, v8 row_newbcast:1 row_mask:0xf bank_mask:0xf
    v_and_b32_dpp v17, v29, v9 row_newbcast:1 row_mask:0xf bank_mask:0xf
    v_and_b32_dpp v18, v29, v10 row_newbcast:1 row_mask:0xf bank_mask:0xf
    v_and_b32_dpp v19, v29, v11 row_newbcast:1 row_mask:0xf bank_mask:0xf
    s_waitcnt vmcnt(6)
    v_mfma_f32_16x16x32_bf16 v[20:23], v[12:15], v[172:175], v[20:23]
    buffer_load_dwordx4 v[208:211], v2, s[48:51], s87 offen offset:2048 nt
    v_lshlrev_b32 v0, 3, v1
    s_mov_b32 exec_hi, 0
    s_mov_b32 exec_lo, s43
    buffer_load_dwordx2 v[6:7], v0, s[64:67], s42 offen sc1 nt
    s_mov_b64 exec, -1
    v_and_b32_dpp v12, v29, v8 row_newbcast:2 row_mask:0xf bank_mask:0xf
    v_and_b32_dpp v13, v29, v9 row_newbcast:2 row_mask:0xf bank_mask:0xf
    v_and_b32_dpp v14, v29, v10 row_newbcast:2 row_mask:0xf bank_mask:0xf
    v_and_b32_dpp v15, v29, v11 row_newbcast:2 row_mask:0xf bank_mask:0xf
    s_waitcnt vmcnt(7)
    v_mfma_f32_16x16x32_bf16 v[20:23], v[16:19], v[188:191], v[20:23]
    buffer_load_dwordx4 v[212:215], v2, s[48:51], s87 offen offset:3072 nt
    v_and_b32_dpp v16, v29, v8 row_newbcast:3 row_mask:0xf bank_mask:0xf
    v_and_b32_dpp v17, v29, v9 row_newbcast:3 row_mask:0xf bank_mask:0xf
    v_and_b32_dpp v18, v29, v10 row_newbcast:3 row_mask:0xf bank_mask:0xf
    v_and_b32_dpp v19, v29, v11 row_newbcast:3 row_mask:0xf bank_mask:0xf
    s_waitcnt vmcnt(7)
    v_mfma_f32_16x16x32_bf16 v[20:23], v[12:15], v[192:195], v[20:23]
    buffer_load_dwordx4 v[216:219], v2, s[48:51], s88 offen offset:0 nt
    v_and_b32_dpp v12, v29, v8 row_newbcast:4 row_mask:0xf bank_mask:0xf
    v_and_b32_dpp v13, v29, v9 row_newbcast:4 row_mask:0xf bank_mask:0xf
    v_and_b32_dpp v14, v29, v10 row_newbcast:4 row_mask:0xf bank_mask:0xf
    v_and_b32_dpp v15, v29, v11 row_newbcast:4 row_mask:0xf bank_mask:0xf
    s_waitcnt vmcnt(7)
    v_mfma_f32_16x16x32_bf16 v[20:23], v[16:19], v[196:199], v[20:23]
    buffer_load_dwordx4 v[220:223], v2, s[48:51], s88 offen offset:1024 nt
    v_and_b32_dpp v16, v29, v8 row_newbcast:5 row_mask:0xf bank_mask:0xf
    v_and_b32_dpp v17, v29, v9 row_newbcast:5 row_mask:0xf bank_mask:0xf
    v_and_b32_dpp v18, v29, v10 row_newbcast:5 row_mask:0xf bank_mask:0xf
    v_and_b32_dpp v19, v29, v11 row_newbcast:5 row_mask:0xf bank_mask:0xf
    s_waitcnt vmcnt(7)
    v_mfma_f32_16x16x32_bf16 v[20:23], v[12:15], v[200:203], v[20:23]
    buffer_load_dwordx4 v[224:227], v2, s[48:51], s88 offen offset:2048 nt
    v_and_b32_dpp v12, v29, v8 row_newbcast:6 row_mask:0xf bank_mask:0xf
    v_and_b32_dpp v13, v29, v9 row_newbcast:6 row_mask:0xf bank_mask:0xf
    v_and_b32_dpp v14, v29, v10 row_newbcast:6 row_mask:0xf bank_mask:0xf
    v_and_b32_dpp v15, v29, v11 row_newbcast:6 row_mask:0xf bank_mask:0xf
    s_waitcnt vmcnt(7)
    v_mfma_f32_16x16x32_bf16 v[20:23], v[16:19], v[204:207], v[20:23]
    buffer_load_dwordx4 v[228:231], v2, s[48:51], s88 offen offset:3072 nt
    v_and_b32_dpp v16, v29, v8 row_newbcast:7 row_mask:0xf bank_mask:0xf
    v_and_b32_dpp v17, v29, v9 row_newbcast:7 row_mask:0xf bank_mask:0xf
    v_and_b32_dpp v18, v29, v10 row_newbcast:7 row_mask:0xf bank_mask:0xf
    v_and_b32_dpp v19, v29, v11 row_newbcast:7 row_mask:0xf bank_mask:0xf
    s_waitcnt vmcnt(7)
    s_waitcnt vmcnt(6)
    v_mfma_f32_16x16x32_bf16 v[20:23], v[12:15], v[208:211], v[20:23]
    buffer_load_dwordx4 v[232:235], v2, s[48:51], s89 offen offset:0 nt
    v_and_b32_dpp v12, v29, v8 row_newbcast:8 row_mask:0xf bank_mask:0xf
    v_and_b32_dpp v13, v29, v9 row_newbcast:8 row_mask:0xf bank_mask:0xf
    v_and_b32_dpp v14, v29, v10 row_newbcast:8 row_mask:0xf bank_mask:0xf
    v_and_b32_dpp v15, v29, v11 row_newbcast:8 row_mask:0xf bank_mask:0xf
    s_waitcnt vmcnt(6)
    s_waitcnt vmcnt(5)
    v_mfma_f32_16x16x32_bf16 v[20:23], v[16:19], v[212:215], v[20:23]
    buffer_load_dwordx4 v[236:239], v2, s[48:51], s89 offen offset:1024 nt
    v_and_b32_dpp v16, v29, v8 row_newbcast:9 row_mask:0xf bank_mask:0xf
    v_and_b32_dpp v17, v29, v9 row_newbcast:9 row_mask:0xf bank_mask:0xf
    v_and_b32_dpp v18, v29, v10 row_newbcast:9 row_mask:0xf bank_mask:0xf
    v_and_b32_dpp v19, v29, v11 row_newbcast:9 row_mask:0xf bank_mask:0xf
    s_waitcnt vmcnt(5)
    v_mfma_f32_16x16x32_bf16 v[20:23], v[12:15], v[216:219], v[20:23]
    buffer_load_dwordx4 v[240:243], v2, s[48:51], s89 offen offset:2048 nt
    v_and_b32_dpp v12, v29, v8 row_newbcast:10 row_mask:0xf bank_mask:0xf
    v_and_b32_dpp v13, v29, v9 row_newbcast:10 row_mask:0xf bank_mask:0xf
    v_and_b32_dpp v14, v29, v10 row_newbcast:10 row_mask:0xf bank_mask:0xf
    v_and_b32_dpp v15, v29, v11 row_newbcast:10 row_mask:0xf bank_mask:0xf
    s_waitcnt vmcnt(5)
    v_mfma_f32_16x16x32_bf16 v[20:23], v[16:19], v[220:223], v[20:23]
    buffer_load_dwordx4 v[244:247], v2, s[48:51], s89 offen offset:3072 nt
    v_and_b32_dpp v16, v29, v8 row_newbcast:11 row_mask:0xf bank_mask:0xf
    v_and_b32_dpp v17, v29, v9 row_newbcast:11 row_mask:0xf bank_mask:0xf
    v_and_b32_dpp v18, v29, v10 row_newbcast:11 row_mask:0xf bank_mask:0xf
    v_and_b32_dpp v19, v29, v11 row_newbcast:11 row_mask:0xf bank_mask:0xf
    s_waitcnt vmcnt(5)
    v_mfma_f32_16x16x32_bf16 v[20:23], v[12:15], v[224:227], v[20:23]
    v_and_b32_dpp v12, v29, v8 row_newbcast:12 row_mask:0xf bank_mask:0xf
    v_and_b32_dpp v13, v29, v9 row_newbcast:12 row_mask:0xf bank_mask:0xf
    v_and_b32_dpp v14, v29, v10 row_newbcast:12 row_mask:0xf bank_mask:0xf
    v_and_b32_dpp v15, v29, v11 row_newbcast:12 row_mask:0xf bank_mask:0xf
    s_waitcnt vmcnt(4)
    v_mfma_f32_16x16x32_bf16 v[20:23], v[16:19], v[228:231], v[20:23]
    v_and_b32_dpp v16, v29, v8 row_newbcast:13 row_mask:0xf bank_mask:0xf
    v_and_b32_dpp v17, v29, v9 row_newbcast:13 row_mask:0xf bank_mask:0xf
    v_and_b32_dpp v18, v29, v10 row_newbcast:13 row_mask:0xf bank_mask:0xf
    v_and_b32_dpp v19, v29, v11 row_newbcast:13 row_mask:0xf bank_mask:0xf
    s_waitcnt vmcnt(3)
    v_mfma_f32_16x16x32_bf16 v[20:23], v[12:15], v[232:235], v[20:23]
    v_mov_b64 v[248:249], 0
    v_mov_b64 v[250:251], 0
    v_mov_b64 v[252:253], 0
    v_mov_b64 v[254:255], 0
    v_mov_b64 v[72:73], 0
    v_mov_b64 v[74:75], 0
    v_mov_b64 v[88:89], 0
    v_mov_b64 v[90:91], 0
    v_and_b32_dpp v12, v29, v8 row_newbcast:14 row_mask:0xf bank_mask:0xf
    v_and_b32_dpp v13, v29, v9 row_newbcast:14 row_mask:0xf bank_mask:0xf
    v_and_b32_dpp v14, v29, v10 row_newbcast:14 row_mask:0xf bank_mask:0xf
    v_and_b32_dpp v15, v29, v11 row_newbcast:14 row_mask:0xf bank_mask:0xf
    s_waitcnt vmcnt(2)
    v_mfma_f32_16x16x32_bf16 v[20:23], v[16:19], v[236:239], v[20:23]
    s_mov_b32 s90, 20000
L_ex_a:
    v_bitop3_b32 v32, v37, s75, v38 bitop3:0x14
    v_bitop3_b32 v32, v32, s75, v36 bitop3:0xf6
    v_and_b32 v32, 0xffff, v32
    v_cmp_ne_u32 vcc, 0, v32
    s_cbranch_vccz L_ex_ok_a
    s_sub_u32 s90, s90, 1
    s_cbranch_scc1 L_ex_ok_a
    s_sleep 4
    buffer_load_dwordx2 v[36:37], v62, s[64:67], s94 offen sc1 nt
    s_waitcnt vmcnt(0)
    s_branch L_ex_a
L_ex_ok_a:
    v_and_b32 v36, 0xffff0000, v36
    s_nop 1
    v_max_f32_dpp v32, v36, v36 row_ror:8 row_mask:0xf bank_mask:0xf
    s_nop 1
    v_max_f32_dpp v32, v32, v32 row_ror:4 row_mask:0xf bank_mask:0xf
    s_nop 1
    v_max_f32_dpp v32, v32, v32 row_ror:2 row_mask:0xf bank_mask:0xf
    s_nop 1
    v_max_f32_dpp v32, v32, v32 row_ror:1 row_mask:0xf bank_mask:0xf
    v_sub_f32 v36, v36, v32
    v_sub_f32 v33, s96, v32
    v_mul_f32 v36, s80, v36
    v_mul_f32 v33, s80, v33
    v_exp_f32 v36, v36
    v_exp_f32 v33, v33
    v_mul_f32 v36, v36, v37
    s_nop 1
    v_add_f32_dpp v36, v36, v36 row_ror:8 row_mask:0xf bank_mask:0xf
    s_nop 1
    v_add_f32_dpp v36, v36, v36 row_ror:4 row_mask:0xf bank_mask:0xf
    s_nop 1
    v_add_f32_dpp v36, v36, v36 row_ror:2 row_mask:0xf bank_mask:0xf
    s_nop 1
    v_add_f32_dpp v36, v36, v36 row_ror:1 row_mask:0xf bank_mask:0xf
    v_rcp_f32 v36, v36
    s_nop 0
    v_mul_f32 v63, v33, v36
    v_and_b32_dpp v16, v29, v8 row_newbcast:15 row_mask:0xf bank_mask:0xf
    v_and_b32_dpp v17, v29, v9 row_newbcast:15 row_mask:0xf bank_mask:0xf
    v_and_b32_dpp v18, v29, v10 row_newbcast:15 row_mask:0xf bank_mask:0xf
    v_and_b32_dpp v19, v29, v11 row_newbcast:15 row_mask:0xf bank_mask:0xf
    s_waitcnt vmcnt(1)
    v_mfma_f32_16x16x32_bf16 v[20:23], v[12:15], v[240:243], v[20:23]
    s_cmp_eq_u32 s43, 0
    s_cbranch_scc1 L_nu_done
L_nu:
    v_cmp_ne_u32 vcc, s97, v6
    s_nop 0
    s_and_b32 s13, vcc_lo, 0xff
    s_cbranch_scc0 L_nu_ok
    s_sub_u32 s90, s90, 1
    s_cbranch_scc1 L_nu_ok
    s_sleep 4
    s_mov_b64 exec, 0xff
    buffer_load_dwordx2 v[6:7], v0, s[64:67], s42 offen sc1 nt
    s_mov_b64 exec, -1
    s_waitcnt vmcnt(0)
    s_branch L_nu
L_nu_ok:
    v_min_u32_dpp v7, v7, v7 row_half_mirror row_mask:0xf bank_mask:0xf
    s_nop 1
    v_min_u32_dpp v7, v7, v7 quad_perm:[3,2,1,0] row_mask:0xf bank_mask:0xf
    s_nop 0
    v_readlane_b32 s42, v7, 0
    v_readlane_b32 s43, v7, 1
    s_nop 0
    s_cmp_lt_u32 s42, s43
    s_cselect_b32 s42, 0x2000, 0
    s_cselect_b32 s43, 32, 0
    s_xor_b32 s91, s91, s42
    s_xor_b32 s93, s93, s43
L_nu_done:
    s_nop 1
    s_waitcnt vmcnt(0)
    v_mfma_f32_16x16x32_bf16 v[20:23], v[16:19], v[244:247], v[20:23]
    s_nop 7
    v_mul_f32 v20, v63, v20
    v_mul_f32 v21, v63, v21
    v_mul_f32 v22, v63, v22
    v_mul_f32 v23, v63, v23
    v_cvt_pk_bf16_f32 v20, v20, v21
    v_cvt_pk_bf16_f32 v21, v22, v23
    ds_write2_b32 v60, v20, v21 offset0:0 offset1:36
    s_waitcnt lgkmcnt(0)
    s_barrier
    ds_read_b128 v[40:43], v59 offset:8192
    ds_read_b128 v[44:47], v59 offset:8256
    s_waitcnt lgkmcnt(1)
    v_smfmac_f32_16x16x64_bf16 v[248:251], v[40:43], v[64:71], v39
    v_smfmac_f32_16x16x64_bf16 v[252:255], v[40:43], v[80:87], v39
    v_smfmac_f32_16x16x64_bf16 v[72:75], v[40:43], v[96:103], v39
    v_smfmac_f32_16x16x64_bf16 v[88:91], v[40:43], v[112:119], v39
    s_waitcnt lgkmcnt(0)
    v_smfmac_f32_16x16x64_bf16 v[248:251], v[44:47], v[160:167], v39
    v_smfmac_f32_16x16x64_bf16 v[252:255], v[44:47], v[176:183], v39
    v_smfmac_f32_16x16x64_bf16 v[72:75], v[44:47], v[124:131], v39
    v_smfmac_f32_16x16x64_bf16 v[88:91], v[44:47], v[132:139], v39
    s_nop 4
    v_pk_add_f32 v[12:13], v[248:249], v[250:251]
    v_pk_add_f32 v[16:17], v[252:253], v[254:255]
    v_pk_add_f32 v[20:21], v[72:73], v[74:75]
    v_pk_add_f32 v[24:25], v[88:89], v[90:91]
    v_add_f32 v12, v12, v13
    v_add_f32 v16, v16, v17
    v_add_f32 v20, v20, v21
    v_add_f32 v24, v24, v25
    v_permlane32_swap_b32 v12, v16
    s_nop 0
    v_permlane32_swap_b32 v20, v24
    v_add_f32 v12, v12, v16
    v_add_f32 v20, v20, v24
    s_nop 1
    v_permlane16_swap_b32 v12, v20
    v_add_f32 v12, v12, v20
    v_and_or_b32 v12, v12, v38, s73
    buffer_store_dword v12, v58, s[64:67], s95 offen sc1
    s_and_b32 s13, s15, 1
    s_cbranch_scc1 L_end1
    s_barrier
    s_cmp_lg_u32 s8, 0
    s_cbranch_scc1 L_end1
    v_lshlrev_b32 v128, 4, v1
    v_add_u32 v129, 0x1000, v128
    s_mov_b32 s90, 20000
    v_bfe_u32 v130, v1, 4, 1
    v_bfe_u32 v131, v1, 5, 1
    v_lshl_add_u32 v130, v130, 1, v131
    v_and_b32 v131, 3, v1
    v_lshl_add_u32 v130, v131, 2, v130
    v_lshlrev_b32 v130, 1, v130
    buffer_load_dwordx4 v[64:67], v128, s[64:67], s91 offen offset:0 sc1 nt
    buffer_load_dwordx4 v[68:71], v128, s[64:67], s91 offen offset:1024 sc1 nt
    buffer_load_dwordx4 v[72:75], v128, s[64:67], s91 offen offset:2048 sc1 nt
    buffer_load_dwordx4 v[76:79], v128, s[64:67], s91 offen offset:3072 sc1 nt
L_slowp:
    s_waitcnt vmcnt(0)
L_chk:
    v_xor_b32 v136, s73, v64
    v_xor_b32 v137, s73, v68
    v_xor_b32 v138, s73, v72
    v_xor_b32 v139, s73, v76
    v_bitop3_b32 v136, v136, s73, v65 bitop3:0xf6
    v_bitop3_b32 v137, v137, s73, v69 bitop3:0xf6
    v_bitop3_b32 v138, v138, s73, v73 bitop3:0xf6
    v_bitop3_b32 v139, v139, s73, v77 bitop3:0xf6
    v_bitop3_b32 v136, v136, s73, v66 bitop3:0xf6
    v_bitop3_b32 v137, v137, s73, v70 bitop3:0xf6
    v_bitop3_b32 v138, v138, s73, v74 bitop3:0xf6
    v_bitop3_b32 v139, v139, s73, v78 bitop3:0xf6
    v_bitop3_b32 v136, v136, s73, v67 bitop3:0xf6
    v_bitop3_b32 v137, v137, s73, v71 bitop3:0xf6
    v_bitop3_b32 v138, v138, s73, v75 bitop3:0xf6
    v_bitop3_b32 v139, v139, s73, v79 bitop3:0xf6
    v_and_b32 v136, 0xfff, v136
    v_and_b32 v137, 0xfff, v137
    v_and_b32 v138, 0xfff, v138
    v_and_b32 v139, 0xfff, v139
    v_cmp_ne_u32 s[44:45], 0, v136
    v_cmp_ne_u32 s[46:47], 0, v137
    v_cmp_ne_u32 s[48:49], 0, v138
    v_cmp_ne_u32 s[50:51], 0, v139
    s_or_b64 s[60:61], s[44:45], s[46:47]
    s_or_b64 s[60:61], s[60:61], s[48:49]
    s_or_b64 s[60:61], s[60:61], s[50:51]
    s_cbranch_scc0 L_poll_ok
    s_mov_b64 exec, s[44:45]
    buffer_load_dwordx4 v[64:67], v128, s[64:67], s91 offen offset:0 sc1 nt
    s_mov_b64 exec, s[46:47]
    buffer_load_dwordx4 v[68:71], v128, s[64:67], s91 offen offset:1024 sc1 nt
    s_mov_b64 exec, s[48:49]
    buffer_load_dwordx4 v[72:75], v128, s[64:67], s91 offen offset:2048 sc1 nt
    s_mov_b64 exec, s[50:51]
    buffer_load_dwordx4 v[76:79], v128, s[64:67], s91 offen offset:3072 sc1 nt
    s_mov_b64 exec, -1
    s_sub_u32 s90, s90, 1
    s_cbranch_scc1 L_poll_ok
    s_bcnt1_i32_b64 s13, s[60:61]
    s_waitcnt vmcnt(8)
    s_cmp_le_u32 s13, 16
    s_cbranch_scc1 L_chk
    s_sleep 6
    s_branch L_slowp
L_poll_ok:
    v_add_f32 v144, v64, v68
    v_add_f32 v145, v65, v69
    v_add_f32 v146, v66, v70
    v_add_f32 v147, v67, v71
    v_add_f32 v148, v72, v76
    v_add_f32 v149, v73, v77
    v_add_f32 v150, v74, v78
    v_add_f32 v151, v75, v79
    v_add_f32 v144, v144, v148
    v_add_f32 v145, v145, v149
    v_add_f32 v146, v146, v150
    v_add_f32 v147, v147, v151
    v_permlane32_swap_b32 v144, v145
    s_nop 0
    v_permlane32_swap_b32 v146, v147
    v_add_f32 v144, v144, v145
    v_add_f32 v146, v146, v147
    s_nop 1
    v_permlane16_swap_b32 v144, v146
    v_add_f32 v144, v144, v146
    s_nop 1
    v_add_f32_dpp v144, v144, v144 row_ror:4 row_mask:0xf bank_mask:0xf
    s_nop 1
    v_add_f32_dpp v144, v144, v144 row_ror:8 row_mask:0xf bank_mask:0xf
    v_cvt_pk_bf16_f32 v144, v144, v144
    s_mov_b32 exec_lo, 0x000f000f
    s_mov_b32 exec_hi, 0x000f000f
    buffer_store_short v144, v130, s[68:71], s93 offen
    s_cmp_lg_u32 s15, 0
    s_cbranch_scc1 L_noep
    s_mov_b64 exec, 1
    v_mov_b32 v132, s97
    buffer_store_dword v132, v57, s[64:67], s74 offen
L_noep:
L_end1:
    s_endpgm
.section .rodata,"a"
.p2align 6
.amdhsa_kernel concat_heads__sliding_block_cached__sliding_block_cached__decode_kernel
  .amdhsa_next_free_vgpr 256
  .amdhsa_next_free_sgpr 102
  .amdhsa_accum_offset 256
  .amdhsa_group_segment_fixed_size 0
  .amdhsa_kernarg_size 104
  .amdhsa_user_sgpr_count 2
  .amdhsa_user_sgpr_kernarg_segment_ptr 1
  .amdhsa_system_sgpr_workgroup_id_x 1
.end_amdhsa_kernel
.text
```
